```python
import torch

def _softmax(x, axis=-1):
    return torch.softmax(x, dim=axis)
def _gelu(x):
    return torch.nn.functional.gelu(x, approximate="tanh")
def _silu(x):
    return torch.nn.functional.silu(x)
def _sigmoid(x):
    return torch.sigmoid(x)
def _layernorm(x, axis=-1, eps=1e-5):
    m = x.mean(dim=axis, keepdim=True)
    v = x.var(dim=axis, keepdim=True, unbiased=False)
    return (x - m) / torch.sqrt(v + eps)
def _scatter_add(tgt, idx, src, axis=0):
    return tgt.clone().index_add_(axis, idx, src)
def _segment_sum(src, seg, n):
    out = torch.zeros((n,) + src.shape[1:], dtype=src.dtype)
    return out.index_add_(0, seg, src)
def _pad(x, pw):
    flat = tuple(v for pair in reversed(pw) for v in pair)
    return torch.nn.functional.pad(x, flat)

kernel_name = 'sequential_preLN__sliding_block_cached__dense_activation_silu__decode'

def setup_inputs():

    _w = (lambda a: (lambda t: t.to(torch.bfloat16) if t.is_floating_point() else t)(torch.as_tensor(a)))
    def _A_setup():
        B, Sq, D = 1, 1, 512
        Hq, Hkv, Sk, Dh = 32, 8, 32768, 128
        assert Hq % Hkv == 0, (Hq, Hkv)
        return {
            "x": _w((lambda *s: torch.randn(*s, dtype=torch.bfloat16) * 0.05)(B, Sq, D)),
            "k_cache": _w((lambda *s: torch.randn(*s, dtype=torch.bfloat16) * 3.2)(B, Hkv, Sk, Dh)),
            "v_cache": _w((lambda *s: torch.randn(*s, dtype=torch.bfloat16) * 0.8)(B, Hkv, Sk, Dh)),
            "wq": _w((lambda *s: torch.randn(*s, dtype=torch.bfloat16) * 3.2)(D, Hq * Dh) * (D ** -0.5)),
            "wo": _w((lambda *s: torch.randn(*s, dtype=torch.bfloat16) * 0.8)(Hq * Dh, D) * ((Hq * Dh) ** -0.5)),
        }
    _A_in = _A_setup()

    def _B_setup():
        B, S, D, F = 1, 1, 512, 1792
        return {
            "x": _w((lambda *s: torch.randn(*s, dtype=torch.bfloat16) * 0.05)(B, S, D)),
            "w1": _w((lambda *s: torch.randn(*s, dtype=torch.bfloat16) * 3.2)(D, F) * (D ** -0.5)),
            "w2": _w((lambda *s: torch.randn(*s, dtype=torch.bfloat16) * 0.4)(F, D) * (F ** -0.5)),
        }
    _B_in = _B_setup()

    return {
        "A_x": _A_in["x"],
        "A_k_cache": _A_in["k_cache"],
        "A_v_cache": _A_in["v_cache"],
        "A_wq": _A_in["wq"],
        "A_wo": _A_in["wo"],
        "B_x": _B_in["x"],
        "B_w1": _B_in["w1"],
        "B_w2": _B_in["w2"],
    }

def reference(A_x, A_k_cache, A_v_cache, A_wq, A_wo, B_x, B_w1, B_w2):
    def _A_ref(x, k_cache, v_cache, wq, wo):
        B, Sq, D = x.shape
        Hq, Dh = 32, 128
        Hkv, Sk = k_cache.shape[1], k_cache.shape[2]
        W = min(4096, max(256, Sk // 4))
        rep = Hq // Hkv
        q = (lambda x, *d: x.permute(*d))((x @ wq).reshape(B, Sq, Hq, Dh), 0, 2, 1, 3)
        k = (lambda x, n, axis: torch.repeat_interleave(x, n, dim=axis))(k_cache[:, :, Sk - W:, :], rep, axis=1)
        v = (lambda x, n, axis: torch.repeat_interleave(x, n, dim=axis))(v_cache[:, :, Sk - W:, :], rep, axis=1)
        scores = torch.einsum("bhqd,bhkd->bhqk", q, k) * (Dh ** -0.5)
        p = _softmax(scores, axis=-1)
        o = torch.einsum("bhqk,bhkd->bhqd", p, v)
        return (lambda x, *d: x.permute(*d))(o, 0, 2, 1, 3).reshape(B, Sq, Hq * Dh) @ wo

    def _B_ref(x, w1, w2):
        h = torch.einsum("bsd,df->bsf", x, w1)
        h = _silu(h)
        out = torch.einsum("bsf,fd->bsd", h, w2)
        return out

    x = A_x
    h = x + _A_ref(_layernorm(x, axis=-1), A_k_cache, A_v_cache, A_wq, A_wo)
    h2 = h + _B_ref(_layernorm(h, axis=-1), B_w1, B_w2)
    return h2
```

```asm
; @launch grid=(256,1,1) block=(256,1,1) lds=86016
.amdgcn_target "amdgcn-amd-amdhsa--gfx950"
.text
.p2align 12
.fill 832, 4, 0xbf800000
.globl sequential_preLN__sliding_block_cached__dense_activation_silu__decode_kernel
.p2align 8
.type sequential_preLN__sliding_block_cached__dense_activation_silu__decode_kernel,@function
sequential_preLN__sliding_block_cached__dense_activation_silu__decode_kernel:

    s_lshr_b32 s4, s2, 3
    s_load_dwordx2 s[20:21], s[0:1], 24
    s_load_dwordx2 s[8:9], s[0:1], 0
    s_load_dwordx2 s[24:25], s[0:1], 80
    s_cmp_ge_u32 s4, 32
    s_cbranch_scc1 L_end
    v_lshrrev_b32 v10, 6, v0
    v_and_b32 v1, 63, v0
    v_readfirstlane_b32 s5, v10
    v_bfe_u32 v3, v0, 4, 2
    v_and_b32 v11, 7, v0
    v_lshlrev_b32 v12, 1, v3
    v_xor_b32 v11, v11, v12
    v_lshrrev_b32 v10, 3, v1
    v_lshlrev_b32 v10, 13, v10
    v_lshl_or_b32 v29, v11, 4, v10
    s_and_b32 s3, s2, 7
    s_lshl_b32 s49, s3, 10
    s_and_b32 s50, s4, 7
    s_lshl_b32 s50, s50, 7
    s_add_u32 s49, s49, s50
    s_lshr_b32 s50, s4, 3
    s_lshl_b32 s50, s50, 2
    s_add_u32 s50, s50, s5
    s_lshl_b32 s41, s50, 6
    s_lshl_b32 s50, s50, 18
    s_add_u32 s49, s49, s50
    s_lshl_b32 s50, s5, 12
    s_bitset1_b32 s50, 15
    s_mov_b32 m0, s50
    s_lshl_b32 s23, 1, 17
    s_lshl_b32 s22, 1, 22
    s_movk_i32 s10, 0x400
    s_mov_b32 s11, s23
    s_lshl_b32 s26, 1, 28
    s_mov_b32 s27, s23
    s_mov_b32 s51, 64512
    v_lshlrev_b32 v10, 4, v1
    v_and_b32 v2, 15, v0
    v_lshlrev_b32 v13, 2, v2
    s_waitcnt lgkmcnt(0)
buffer_load_dwordx4 v[200:203], v10, s[8:11], 0 offen
buffer_load_dword v216, v13, s[8:11], s41 offen
buffer_load_dwordx4 v29, s[20:23], s49 offen offset:0 nt lds
s_add_u32 s49, s49, s51
buffer_load_dwordx4 v29, s[20:23], s49 offen offset:1024 nt lds
s_add_u32 s49, s49, s51
buffer_load_dwordx4 v29, s[20:23], s49 offen offset:2048 nt lds
s_add_u32 s49, s49, s51
buffer_load_dwordx4 v29, s[20:23], s49 offen offset:3072 nt lds

    s_load_dwordx2 s[12:13], s[0:1], 8
    s_load_dwordx2 s[16:17], s[0:1], 16
    buffer_load_dword v249, off, s[24:27], 0 sc1
    s_load_dwordx2 s[28:29], s[0:1], 32
    s_load_dwordx2 s[32:33], s[0:1], 48
    s_load_dwordx2 s[30:31], s[0:1], 56
    s_load_dwordx2 s[34:35], s[0:1], 64

    s_mov_b32 s18, 67108864
    s_mov_b32 s19, 0x20000
    v_lshlrev_b32 v29, 4, v2
    v_lshl_or_b32 v8, v3, 10, v29
    s_mov_b32 s6, 0
    s_mov_b32 s64, 0x05040100
    s_mov_b32 s65, 0x07060302
    s_mov_b32 s58, 0x3fb8aa3b
    s_mov_b32 s59, 0x3fb8aa3b
    s_mov_b32 s60, 0x3db504f3
    s_mov_b32 s61, 0x3db504f3
    v_cmp_eq_u32 s[52:53], 1, v3
    v_cmp_eq_u32 s[54:55], 2, v3
    v_cmp_eq_u32 s[56:57], 3, v3
    s_lshl_b32 s48, s5, 6
    s_add_u32 s48, s48, 65536
    v_bfe_u32 v29, v2, 1, 2
    v_lshlrev_b32 v240, 4, v29
    v_lshrrev_b32 v29, 3, v2
    v_lshl_or_b32 v240, v29, 3, v240
    v_and_b32 v29, 1, v2
    v_lshl_or_b32 v240, v29, 2, v240
    v_add_u32 v240, s48, v240
    v_lshl_add_u32 v241, v3, 4, s48
    s_lshl_b32 s48, s5, 12
    s_add_u32 s48, s48, 32768
    v_lshrrev_b32 v29, 2, v2
    v_lshl_or_b32 v30, v3, 2, v29
    v_bfe_u32 v31, v30, 1, 2
    v_lshlrev_b32 v30, 7, v30
    v_lshl_or_b32 v30, v31, 5, v30
    v_and_b32 v31, 3, v2
    v_lshl_or_b32 v30, v31, 3, v30
    v_add_u32 v242, s48, v30
    v_xor_b32 v243, 32, v242
    v_xor_b32 v244, 64, v242
    v_xor_b32 v245, 96, v242
    s_lshl_b32 s48, s5, 2
    s_add_u32 s48, s48, 78976
    v_lshl_add_u32 v220, v1, 4, s48
    s_lshl_b32 s48, s5, 8
    s_add_u32 s48, s48, 78976
    v_lshl_add_u32 v221, v2, 4, s48
    s_lshl_b32 s62, s3, 14
    s_add_u32 s62, s62, 262144
    s_lshr_b32 s48, s4, 3
    s_lshl_b32 s48, s48, 12
    s_and_b32 s49, s4, 7
    s_lshl_b32 s49, s49, 9
    s_add_u32 s48, s48, s49
    s_lshl_b32 s49, s5, 7
    s_add_u32 s48, s48, s49
    s_add_u32 s40, s48, s62
    v_lshrrev_b32 v222, 1, v2
    v_lshlrev_b32 v222, 4, v222

    s_lshl_b32 s44, s3, 23
    s_lshl_b32 s48, s4, 12
    s_add_u32 s44, s44, s48
    s_lshl_b32 s48, s5, 18
    s_add_u32 s44, s44, s48
    s_add_u32 s44, s44, 7340032
    s_add_u32 s45, s44, 131072
    v_xor_b32 v29, v2, v3
    v_lshlrev_b32 v29, 4, v29
    v_lshl_or_b32 v4, v3, 8, v29
    v_xor_b32 v5, 64, v4
    v_xor_b32 v6, 128, v4
    v_xor_b32 v7, 192, v4
    s_lshl_b32 s48, s5, 13
    s_mov_b32 m0, s48
    s_mov_b32 s14, 67108864
    s_mov_b32 s15, 0x20000
    s_waitcnt lgkmcnt(0)
buffer_load_dwordx4 v4, s[12:15], s44 offen offset:0 nt lds
buffer_load_dwordx4 v5, s[12:15], s44 offen offset:1024 nt lds
buffer_load_dwordx4 v6, s[12:15], s44 offen offset:2048 nt lds
buffer_load_dwordx4 v7, s[12:15], s44 offen offset:3072 nt lds
s_add_u32 s48, s48, 4096
s_mov_b32 m0, s48
    s_nop 0
buffer_load_dwordx4 v4, s[12:15], s45 offen offset:0 nt lds
buffer_load_dwordx4 v5, s[12:15], s45 offen offset:1024 nt lds
buffer_load_dwordx4 v6, s[12:15], s45 offen offset:2048 nt lds
buffer_load_dwordx4 v7, s[12:15], s45 offen offset:3072 nt lds
s_waitcnt vmcnt(14)
v_lshlrev_b32 v204, 16, v200
v_and_b32 v205, 0xffff0000, v200
v_lshlrev_b32 v206, 16, v201
v_and_b32 v207, 0xffff0000, v201
v_lshlrev_b32 v208, 16, v202
v_and_b32 v209, 0xffff0000, v202
v_lshlrev_b32 v210, 16, v203
v_and_b32 v211, 0xffff0000, v203

    v_pk_add_f32 v[144:145], v[204:205], v[206:207]
    v_pk_add_f32 v[146:147], v[208:209], v[210:211]
    v_pk_add_f32 v[144:145], v[144:145], v[146:147]
    v_add_f32 v212, v144, v145
    s_nop 1
v_add_f32_dpp v212, v212, v212 row_ror:8 row_mask:0xf bank_mask:0xf
    s_nop 1
v_add_f32_dpp v212, v212, v212 row_ror:4 row_mask:0xf bank_mask:0xf
    s_nop 1
v_add_f32_dpp v212, v212, v212 row_ror:2 row_mask:0xf bank_mask:0xf
    s_nop 1
v_add_f32_dpp v212, v212, v212 row_ror:1 row_mask:0xf bank_mask:0xf
v_mov_b32 v213, v212
    s_nop 1
v_permlane16_swap_b32 v212, v213
v_add_f32 v212, v212, v213
v_mov_b32 v213, v212
    s_nop 1
v_permlane32_swap_b32 v212, v213
v_add_f32 v212, v212, v213
v_mul_f32 v212, 0xbb000000, v212
v_mov_b32 v213, v212
v_pk_add_f32 v[144:145], v[204:205], v[212:213]
v_pk_add_f32 v[146:147], v[206:207], v[212:213]
v_pk_add_f32 v[148:149], v[208:209], v[212:213]
v_pk_add_f32 v[150:151], v[210:211], v[212:213]
v_pk_mul_f32 v[204:205], v[144:145], v[144:145]
v_pk_fma_f32 v[204:205], v[146:147], v[146:147], v[204:205]
v_pk_fma_f32 v[204:205], v[148:149], v[148:149], v[204:205]
v_pk_fma_f32 v[204:205], v[150:151], v[150:151], v[204:205]
v_add_f32 v213, v204, v205
v_mul_f32 v212, -1.0, v212
    s_nop 0
v_add_f32_dpp v213, v213, v213 row_ror:8 row_mask:0xf bank_mask:0xf
    s_nop 1
v_add_f32_dpp v213, v213, v213 row_ror:4 row_mask:0xf bank_mask:0xf
    s_nop 1
v_add_f32_dpp v213, v213, v213 row_ror:2 row_mask:0xf bank_mask:0xf
    s_nop 1
v_add_f32_dpp v213, v213, v213 row_ror:1 row_mask:0xf bank_mask:0xf
v_mov_b32 v214, v213
    s_nop 1
v_permlane16_swap_b32 v213, v214
v_add_f32 v213, v213, v214
v_mov_b32 v214, v213
    s_nop 1
v_permlane32_swap_b32 v213, v214
v_add_f32 v213, v213, v214
v_mul_f32 v213, 0x3b000000, v213
v_cvt_pk_bf16_f32 v212, v212, v212
v_lshlrev_b32 v212, 16, v212
v_cvt_pk_bf16_f32 v213, v213, v213
v_lshlrev_b32 v213, 16, v213
v_add_f32 v213, 0x3727c5ac, v213
v_cvt_pk_bf16_f32 v213, v213, v213
v_lshlrev_b32 v213, 16, v213
v_sqrt_f32 v213, v213
    s_nop 0
v_cvt_pk_bf16_f32 v213, v213, v213
v_lshlrev_b32 v213, 16, v213

    v_rcp_f32 v214, v213
    s_waitcnt vmcnt(13)
    v_lshlrev_b32 v204, 16, v216
    v_and_b32 v205, 0xffff0000, v216
    v_sub_f32 v204, v204, v212
    v_sub_f32 v205, v205, v212
    v_cvt_pk_bf16_f32 v216, v204, v205
    v_lshlrev_b32 v204, 16, v216
    v_and_b32 v205, 0xffff0000, v216
    v_mul_f32 v206, v204, v214
    v_mul_f32 v207, v205, v214
    v_fma_f32 v204, -v206, v213, v204
    v_fma_f32 v205, -v207, v213, v205
    v_fma_f32 v204, v204, v214, v206
    v_fma_f32 v205, v205, v214, v207
    v_cvt_pk_bf16_f32 v216, v204, v205
s_mov_b32 exec_lo, 0xffff
s_mov_b32 exec_hi, 0x0
ds_write_b32 v240, v216
s_mov_b64 exec, -1

    s_waitcnt lgkmcnt(0)
    ds_read_b128 v[128:131], v241
buffer_load_dwordx4 v[64:67], v8, s[16:19], s44 offen offset:0 nt
buffer_load_dwordx4 v[68:71], v8, s[16:19], s44 offen offset:256 nt
buffer_load_dwordx4 v[72:75], v8, s[16:19], s44 offen offset:512 nt
buffer_load_dwordx4 v[76:79], v8, s[16:19], s44 offen offset:768 nt
s_waitcnt vmcnt(12)
ds_read_b64_tr_b16 v[32:33], v242
ds_read_b64_tr_b16 v[34:35], v242 offset:2048
ds_read_b64_tr_b16 v[36:37], v243
ds_read_b64_tr_b16 v[38:39], v243 offset:2048
ds_read_b64_tr_b16 v[40:41], v244
ds_read_b64_tr_b16 v[42:43], v244 offset:2048
ds_read_b64_tr_b16 v[44:45], v245
ds_read_b64_tr_b16 v[46:47], v245 offset:2048

    v_readfirstlane_b32 s46, v249
    s_getreg_b32 s67, hwreg(HW_REG_XCC_ID)
    s_nop 1
    s_add_u32 s46, s46, 0x9e3779b8
    s_or_b32 s46, s46, 1
    s_xor_b32 s47, s46, 0x5bd1e994
    s_and_b32 s67, s67, 7
    s_xor_b32 s67, s67, s47
v_mov_b32 v238, s46
v_mov_b32 v239, s67
s_waitcnt lgkmcnt(0)
v_mfma_f32_16x16x32_bf16 v[160:163], v[128:131], v[32:35], 0
v_mfma_f32_16x16x32_bf16 v[164:167], v[128:131], v[36:39], 0
v_mfma_f32_16x16x32_bf16 v[168:171], v[128:131], v[40:43], 0
v_mfma_f32_16x16x32_bf16 v[172:175], v[128:131], v[44:47], 0

    s_nop 5
    v_cndmask_b32 v200, v160, v164, s[52:53]
    v_cndmask_b32 v200, v200, v168, s[54:55]
    v_cndmask_b32 v200, v200, v172, s[56:57]
    ds_write_b32 v220, v200
    s_waitcnt lgkmcnt(0)
    s_barrier
    ds_read_b128 v[204:207], v221
    s_waitcnt lgkmcnt(0)
    v_pk_add_f32 v[204:205], v[204:205], v[206:207]
    v_add_f32 v236, v204, v205
    s_nop 1
    v_mov_b32_dpp v237, v236 quad_perm:[1,1,3,3] row_mask:0xf bank_mask:0xf
s_mov_b32 exec_lo, 0x5555
s_mov_b32 exec_hi, 0x0
buffer_store_dwordx4 v[236:239], v222, s[24:27], s40 offen
s_xor_b32 s40, s40, 131072
buffer_store_dwordx4 v[236:239], v222, s[24:27], s40 offen sc1
s_mov_b64 exec, -1
buffer_load_dwordx4 v[80:83], v8, s[16:19], s45 offen offset:0 nt
buffer_load_dwordx4 v[84:87], v8, s[16:19], s45 offen offset:256 nt
buffer_load_dwordx4 v[88:91], v8, s[16:19], s45 offen offset:512 nt
buffer_load_dwordx4 v[92:95], v8, s[16:19], s45 offen offset:768 nt

    s_lshl_b32 s48, s5, 13
    v_xor_b32 v29, v2, v3
    v_lshlrev_b32 v29, 4, v29
    v_lshl_or_b32 v29, v2, 8, v29
    v_add_u32 v20, s48, v29
    v_xor_b32 v21, 64, v20
    v_xor_b32 v22, 128, v20
    v_xor_b32 v23, 192, v20
    v_mov_b32 v252, 0x3f803f80
    v_mov_b32 v253, 0x3f803f80
    v_mov_b32 v254, 0x3f803f80
    v_mov_b32 v255, 0x3f803f80
    s_mul_i32 s48, s5, 272
    s_add_u32 s48, s48, 80640
    v_lshl_add_u32 v16, v1, 2, s48
    v_lshrrev_b32 v17, 2, v2
    v_mul_u32_u24 v17, 272, v17
    v_lshl_add_u32 v17, v3, 4, v17
    v_add_u32 v17, 80640, v17
    s_lshl_b32 s48, s5, 10
    s_add_u32 s62, s62, s48

    s_add_u32 s42, s62, 4096
    s_add_u32 s43, s62, 8192
    s_add_u32 s100, s62, 12288
    v_lshlrev_b32 v9, 4, v1
    s_mul_i32 s48, s5, 2304
    s_add_u32 s48, s48, 69632
    v_mul_u32_u24 v10, 576, v3
    v_mad_u32_u24 v10, v2, 36, v10
    v_add_u32 v10, s48, v10
    s_lshl_b32 s48, s5, 3
    s_add_u32 s48, s48, 78848
    v_lshlrev_b32 v11, 5, v3
    v_add_u32 v11, s48, v11
    s_mul_i32 s48, s5, 576
    s_add_u32 s48, s48, 69632
    v_lshrrev_b32 v12, 2, v1
    v_mul_u32_u24 v12, 36, v12
    v_and_b32 v13, 3, v1
    v_lshl_add_u32 v12, v13, 3, v12
    v_add_u32 v12, s48, v12
    v_add_u32 v13, 2304, v12
    v_add_u32 v14, 4608, v12
    v_add_u32 v15, 6912, v12
    s_lshl_b32 s48, s5, 5
    s_add_u32 s48, s48, 78848
    v_mov_b32 v18, s48
    s_lshl_b32 s48, s5, 2
    s_add_u32 s48, s48, 81728
    v_mov_b32 v27, s48
    s_lshl_b32 s48, s3, 4
    s_lshl_b32 s49, s5, 2
    s_add_u32 s48, s48, s49
    s_lshl_b32 s48, s48, 5
    s_add_u32 s48, s48, s4
    s_lshl_b32 s48, s48, 7
    s_add_u32 s63, s48, 524288
    v_lshrrev_b32 v19, 1, v2
    v_lshlrev_b32 v19, 4, v19
    v_lshl_or_b32 v19, v3, 12, v19
    v_lshlrev_b32 v29, 1, v3
    v_xor_b32 v29, v29, v2
    v_lshlrev_b32 v29, 4, v29
    v_lshl_or_b32 v24, v3, 10, v29
    v_xor_b32 v25, 128, v24
    s_mov_b32 s36, 3072
    s_mov_b32 s37, 7168
    s_lshl_b32 s38, s5, 13
    s_lshr_b32 s39, s4, 1
    s_lshl_b32 s39, s39, 7
    s_and_b32 s48, s4, 1
    s_lshl_b32 s48, s48, 4
    s_add_u32 s39, s39, s48
    v_bfe_u32 v28, v1, 3, 2
    v_lshlrev_b32 v28, 5, v28
    v_and_b32 v29, 7, v1
    v_lshl_or_b32 v28, v29, 1, v28
    s_cmp_ge_u32 s4, 16
    s_cbranch_scc1 L_pre_f
    s_lshl_b32 s66, s3, 4
    s_add_u32 s66, s66, s4
    s_lshl_b32 s69, s66, 12
    s_add_u32 s69, s69, 524288
    s_lshl_b32 s48, s5, 5
    s_add_u32 s69, s69, s48
    v_lshrrev_b32 v26, 1, v1
    v_lshlrev_b32 v26, 7, v26
    v_and_b32 v29, 1, v1
    v_lshl_or_b32 v26, v29, 4, v26
    v_mov_b32 v247, 0
    s_mov_b32 s50, 4194304
    s_waitcnt lgkmcnt(0)
    s_mov_b32 s48, s28
    s_mov_b32 s49, s29
    s_branch L_pre_d
L_pre_f:
    s_mul_i32 s66, s3, 7
    s_add_u32 s66, s66, s4
    s_sub_u32 s66, s66, 16
    s_lshl_b32 s69, s3, 11
    s_add_u32 s69, s69, 4096
    v_lshlrev_b32 v26, 5, v1
    v_lshrrev_b32 v29, 2, v1
    v_mul_u32_u24 v247, 3584, v29
    v_and_b32 v29, 3, v1
    v_lshlrev_b32 v30, 1, v3
    v_and_b32 v30, 2, v30
    v_xor_b32 v29, v29, v30
    v_lshl_add_u32 v247, v29, 4, v247
    s_cmp_ge_u32 s4, 23
    s_cselect_b32 s50, 0, 1835008
    s_waitcnt lgkmcnt(0)
    s_mov_b32 s48, s30
    s_mov_b32 s49, s31
L_pre_d:
    s_mov_b32 s20, s48
    s_mov_b32 s21, s49
    s_mov_b32 s22, s50
    s_lshl_b32 s7, s66, 15
    s_lshl_b32 s48, s5, 8
    s_add_u32 s7, s7, s48

    s_cmp_ge_u32 s4, 16
    s_cselect_b32 s12, s32, s34
    s_cselect_b32 s13, s33, s35
    s_movk_i32 s48, 0x400
    s_cselect_b32 s14, 1835008, s48
    s_mul_i32 s48, s5, 458752
    s_cselect_b32 s48, s48, 0
    buffer_load_dword v251, off, s[12:15], s48
buffer_load_dword v251, off, s[20:23], s7
s_branch L_warm1
L_warm_ret:
s_waitcnt vmcnt(12)
ds_read_b128 v[32:35], v20 offset:0
ds_read_b128 v[36:39], v21 offset:0
ds_read_b128 v[40:43], v22 offset:0
ds_read_b128 v[44:47], v23 offset:0
ds_read_b128 v[48:51], v20 offset:4096
ds_read_b128 v[52:55], v21 offset:4096
ds_read_b128 v[56:59], v22 offset:4096
ds_read_b128 v[60:63], v23 offset:4096
s_waitcnt vmcnt(8)
v_perm_b32 v96, v68, v64, s64
v_perm_b32 v97, v76, v72, s64
v_perm_b32 v100, v68, v64, s65
v_perm_b32 v101, v76, v72, s65
v_perm_b32 v104, v69, v65, s64
v_perm_b32 v105, v77, v73, s64
v_perm_b32 v108, v69, v65, s65
v_perm_b32 v109, v77, v73, s65
v_perm_b32 v112, v70, v66, s64
v_perm_b32 v113, v78, v74, s64
v_perm_b32 v116, v70, v66, s65
v_perm_b32 v117, v78, v74, s65
v_perm_b32 v120, v71, v67, s64
v_perm_b32 v121, v79, v75, s64
v_perm_b32 v124, v71, v67, s65
v_perm_b32 v125, v79, v75, s65
s_waitcnt vmcnt(4)
buffer_load_dwordx4 v[144:147], v9, s[24:27], s62 offen sc1
buffer_load_dwordx4 v[148:151], v9, s[24:27], s42 offen sc1
buffer_load_dwordx4 v[152:155], v9, s[24:27], s43 offen sc1
buffer_load_dwordx4 v[156:159], v9, s[24:27], s100 offen sc1

L_qcheck:
    s_waitcnt vmcnt(0)
L_qchk0:
    v_add_f32 v200, v144, v148
    v_add_f32 v201, v145, v149
    v_add_f32 v202, v152, v156
    v_add_f32 v203, v153, v157
    v_add_f32 v200, v200, v202
    v_add_f32 v201, v201, v203
    v_xor_b32 v146, s46, v146
    v_cvt_pk_bf16_f32 v200, v200, v201
    v_xor_b32 v150, s46, v150
    ds_write_b32 v16, v200
    v_xor_b32 v154, s46, v154
    v_xor_b32 v158, s46, v158
    v_or3_b32 v146, v146, v150, v154
    v_or_b32 v146, v146, v158
    v_cmp_ne_u32 vcc, 0, v146
    s_cbranch_vccz L_qok
    s_sleep 1
s_xor_b32 s62, s62, 131072
s_xor_b32 s42, s42, 131072
s_xor_b32 s43, s43, 131072
s_xor_b32 s100, s100, 131072
buffer_load_dwordx4 v[144:147], v9, s[24:27], s62 offen sc1
buffer_load_dwordx4 v[148:151], v9, s[24:27], s42 offen sc1
buffer_load_dwordx4 v[152:155], v9, s[24:27], s43 offen sc1
buffer_load_dwordx4 v[156:159], v9, s[24:27], s100 offen sc1
s_add_u32 s6, s6, 1
s_cmp_lt_u32 s6, 2097152
s_cbranch_scc1 L_qcheck
s_branch L_fin
L_qok:
s_waitcnt lgkmcnt(0)
s_barrier
ds_read_b128 v[128:131], v17 offset:0
ds_read_b128 v[132:135], v17 offset:64
ds_read_b128 v[136:139], v17 offset:128
ds_read_b128 v[140:143], v17 offset:192
s_mov_b32 m0, s38
    s_nop 0
buffer_load_dwordx4 v24, s[20:23], s7 offen offset:0 nt lds
s_add_u32 s7, s7, s36
buffer_load_dwordx4 v25, s[20:23], s7 offen offset:1024 nt lds
s_add_u32 s7, s7, s36

    v_xor_b32 v147, s67, v147
    v_xor_b32 v151, s67, v151
    v_xor_b32 v155, s67, v155
    v_xor_b32 v159, s67, v159
    v_or3_b32 v147, v147, v151, v155
    v_or_b32 v147, v147, v159
    v_cmp_ne_u32 vcc, 0, v147
    s_cmp_lg_u64 vcc, 0
    s_cselect_b32 s68, 1, 0
    v_mov_b32 v29, s68
s_waitcnt lgkmcnt(0)
v_mfma_f32_16x16x32_bf16 v[192:195], v[32:35], v[128:131], 0
v_mfma_f32_16x16x32_bf16 v[196:199], v[48:51], v[128:131], 0
v_mfma_f32_16x16x32_bf16 v[192:195], v[36:39], v[132:135], v[192:195]
v_mfma_f32_16x16x32_bf16 v[196:199], v[52:55], v[132:135], v[196:199]
v_mfma_f32_16x16x32_bf16 v[192:195], v[40:43], v[136:139], v[192:195]
v_mfma_f32_16x16x32_bf16 v[196:199], v[56:59], v[136:139], v[196:199]
v_mfma_f32_16x16x32_bf16 v[192:195], v[44:47], v[140:143], v[192:195]
v_mfma_f32_16x16x32_bf16 v[196:199], v[60:63], v[140:143], v[196:199]
v_perm_b32 v98, v84, v80, s64
v_perm_b32 v99, v92, v88, s64
v_perm_b32 v102, v84, v80, s65
v_perm_b32 v103, v92, v88, s65
v_perm_b32 v106, v85, v81, s64
v_perm_b32 v107, v93, v89, s64
v_perm_b32 v110, v85, v81, s65
v_perm_b32 v111, v93, v89, s65
v_perm_b32 v114, v86, v82, s64
v_perm_b32 v115, v94, v90, s64
v_perm_b32 v118, v86, v82, s65
v_perm_b32 v119, v94, v90, s65
v_perm_b32 v122, v87, v83, s64
v_perm_b32 v123, v95, v91, s64
v_perm_b32 v126, v87, v83, s65
v_perm_b32 v127, v95, v91, s65
ds_write_b32 v27, v29
buffer_load_dwordx4 v24, s[20:23], s7 offen offset:2048 nt lds
s_add_u32 s7, s7, s36
buffer_load_dwordx4 v25, s[20:23], s7 offen offset:3072 nt lds
s_add_u32 s7, s7, s37
v_cvt_pk_bf16_f32 v208, v192, v193
v_cvt_pk_bf16_f32 v209, v194, v195
v_cvt_pk_bf16_f32 v210, v196, v197
v_cvt_pk_bf16_f32 v211, v198, v199
v_lshlrev_b32 v200, 16, v208
v_and_b32 v201, 0xffff0000, v208
v_lshlrev_b32 v202, 16, v209
v_and_b32 v203, 0xffff0000, v209
v_lshlrev_b32 v204, 16, v210
v_and_b32 v205, 0xffff0000, v210
v_lshlrev_b32 v206, 16, v211
v_and_b32 v207, 0xffff0000, v211
s_add_u32 s38, s38, 4096
s_mov_b32 m0, s38
    s_nop 0
buffer_load_dwordx4 v24, s[20:23], s7 offen offset:0 nt lds
s_add_u32 s7, s7, s36
v_pk_mul_f32 v[200:201], v[200:201], s[60:61]
v_pk_mul_f32 v[202:203], v[202:203], s[60:61]
v_pk_mul_f32 v[204:205], v[204:205], s[60:61]
v_pk_mul_f32 v[206:207], v[206:207], s[60:61]
v_cvt_pk_bf16_f32 v208, v200, v201
v_cvt_pk_bf16_f32 v209, v202, v203
v_cvt_pk_bf16_f32 v210, v204, v205
v_cvt_pk_bf16_f32 v211, v206, v207
v_lshlrev_b32 v200, 16, v208
v_and_b32 v201, 0xffff0000, v208
v_lshlrev_b32 v202, 16, v209
v_and_b32 v203, 0xffff0000, v209
v_lshlrev_b32 v204, 16, v210
v_and_b32 v205, 0xffff0000, v210
v_lshlrev_b32 v206, 16, v211
v_and_b32 v207, 0xffff0000, v211
buffer_load_dwordx4 v25, s[20:23], s7 offen offset:1024 nt lds
s_add_u32 s7, s7, s36

    v_max3_f32 v212, v200, v201, v202
    v_max3_f32 v214, v203, v204, v205
    v_max3_f32 v212, v212, v206, v207
    v_max_f32 v212, v212, v214
    v_mov_b32 v214, v212
    s_nop 1
    v_permlane16_swap_b32 v212, v214
    v_max_f32 v212, v212, v214
    v_mov_b32 v214, v212
    s_nop 1
    v_permlane32_swap_b32 v212, v214
    v_max_f32 v212, v212, v214
    v_mul_f32 v212, s58, v212
v_pk_fma_f32 v[200:201], v[200:201], s[58:59], v[212:213] op_sel_hi:[1,1,0] neg_lo:[0,0,1] neg_hi:[0,0,1]
v_pk_fma_f32 v[202:203], v[202:203], s[58:59], v[212:213] op_sel_hi:[1,1,0] neg_lo:[0,0,1] neg_hi:[0,0,1]
v_pk_fma_f32 v[204:205], v[204:205], s[58:59], v[212:213] op_sel_hi:[1,1,0] neg_lo:[0,0,1] neg_hi:[0,0,1]
v_pk_fma_f32 v[206:207], v[206:207], s[58:59], v[212:213] op_sel_hi:[1,1,0] neg_lo:[0,0,1] neg_hi:[0,0,1]
buffer_load_dwordx4 v24, s[20:23], s7 offen offset:2048 nt lds
s_add_u32 s7, s7, s36
v_exp_f32 v200, v200
v_exp_f32 v201, v201
v_exp_f32 v202, v202
v_exp_f32 v203, v203
v_exp_f32 v204, v204
v_exp_f32 v205, v205
v_exp_f32 v206, v206
v_exp_f32 v207, v207
v_cvt_pk_bf16_f32 v208, v200, v201
v_cvt_pk_bf16_f32 v209, v202, v203
v_cvt_pk_bf16_f32 v210, v204, v205
v_cvt_pk_bf16_f32 v211, v206, v207
    s_nop 1
v_mfma_f32_16x16x32_bf16 v[192:195], v[208:211], v[252:255], 0
v_mfma_f32_16x16x32_bf16 v[160:163], v[208:211], v[96:99], 0
v_mfma_f32_16x16x32_bf16 v[164:167], v[208:211], v[100:103], 0
v_mfma_f32_16x16x32_bf16 v[168:171], v[208:211], v[104:107], 0
v_mfma_f32_16x16x32_bf16 v[172:175], v[208:211], v[108:111], 0
v_mfma_f32_16x16x32_bf16 v[176:179], v[208:211], v[112:115], 0
v_mfma_f32_16x16x32_bf16 v[180:183], v[208:211], v[116:119], 0
v_mfma_f32_16x16x32_bf16 v[184:187], v[208:211], v[120:123], 0
v_mfma_f32_16x16x32_bf16 v[188:191], v[208:211], v[124:127], 0
buffer_load_dwordx4 v25, s[20:23], s7 offen offset:3072 nt lds
v_mov_b32 v213, v192
s_mov_b32 exec_lo, 0x100001
s_mov_b32 exec_hi, 0x10000100
ds_write_b64 v11, v[212:213]
s_mov_b64 exec, -1
ds_write2_b32 v10, v160, v164 offset0:0 offset1:1
ds_write2_b32 v10, v168, v172 offset0:2 offset1:3
ds_write2_b32 v10, v176, v180 offset0:4 offset1:5
ds_write2_b32 v10, v184, v188 offset0:6 offset1:7

    v_mov_b32 v30, 81728
    v_mov_b32 v239, s46
    s_waitcnt lgkmcnt(0)
    s_barrier
    ds_read_b128 v[216:219], v18
    ds_read_b128 v[220:223], v18 offset:16
ds_read2_b32 v[224:225], v12 offset0:0 offset1:1
ds_read2_b32 v[226:227], v13 offset0:0 offset1:1
ds_read2_b32 v[228:229], v14 offset0:0 offset1:1
ds_read2_b32 v[230:231], v15 offset0:0 offset1:1
ds_read_b128 v[144:147], v30
buffer_load_ushort v248, v28, s[8:11], s39 offen
buffer_load_dword v251, v26, s[24:27], s69 offen sc1

    s_waitcnt lgkmcnt(5)
    v_max3_f32 v232, v216, v218, v220
    v_max_f32 v232, v232, v222
    v_sub_f32 v216, v216, v232
    v_sub_f32 v218, v218, v232
    v_sub_f32 v220, v220, v232
    v_sub_f32 v222, v222, v232
    v_exp_f32 v216, v216
    v_exp_f32 v218, v218
    v_exp_f32 v220, v220
    v_exp_f32 v222, v222
    v_mul_f32 v233, v216, v217
    v_fmac_f32 v233, v218, v219
    v_fmac_f32 v233, v220, v221
    v_fmac_f32 v233, v222, v223
    s_waitcnt lgkmcnt(0)
    v_rcp_f32 v234, v233
    v_log_f32 v235, v233
    v_mul_f32 v224, v224, v216
    v_mul_f32 v225, v225, v216
    v_fmac_f32 v224, v226, v218
    v_fmac_f32 v225, v227, v218
    v_fmac_f32 v224, v228, v220
    v_fmac_f32 v225, v229, v220
    v_fmac_f32 v224, v230, v222
    v_fmac_f32 v225, v231, v222
    v_or3_b32 v144, v144, v145, v146
    v_mul_f32 v224, v224, v234
    v_mul_f32 v225, v225, v234
    v_or_b32 v144, v144, v147
    v_add_f32 v238, v232, v235
    v_cvt_pk_bf16_f32 v236, v224, v225
    v_readfirstlane_b32 s68, v144
    s_nop 0
v_mov_b32_dpp v237, v236 quad_perm:[1,1,3,3] row_mask:0xf bank_mask:0xf
s_mov_b32 exec_lo, 0x55555555
s_mov_b32 exec_hi, 0x55555555
s_cmp_lg_u32 s68, 0
s_cbranch_scc1 L_lsg1
buffer_store_dwordx4 v[236:239], v19, s[24:27], s63 offen
s_branch L_lsd1
L_lsg1:
buffer_store_dwordx4 v[236:239], v19, s[24:27], s63 offen sc1
L_lsd1:
s_mov_b64 exec, -1
s_cmp_ge_u32 s4, 16
s_cbranch_scc1 L_ftail

    v_lshrrev_b32 v15, 2, v2
    v_lshl_or_b32 v15, v3, 2, v15
    v_and_b32 v16, 7, v15
    v_lshlrev_b32 v16, 5, v16
    v_lshl_or_b32 v16, v15, 8, v16
    v_and_b32 v15, 3, v2
    v_lshl_or_b32 v16, v15, 3, v16
    s_lshl_b32 s48, s5, 13
    v_add_u32 v14, s48, v16
v_xor_b32 v65, 32, v14
v_xor_b32 v66, 64, v14
v_xor_b32 v67, 96, v14
v_xor_b32 v68, 128, v14
v_xor_b32 v69, 160, v14
v_xor_b32 v70, 192, v14
v_xor_b32 v71, 224, v14

    s_mov_b32 s58, 0x3f80
    s_mov_b32 s59, 0x3f800000
    s_lshr_b32 s60, s4, 1
    s_lshl_b32 s60, s60, 6
    s_and_b32 s49, s4, 1
    s_lshl_b32 s49, s49, 3
    s_add_u32 s60, s60, s49
    v_and_b32 v18, 1, v1
    v_and_b32 v19, 1, v3
    v_lshlrev_b32 v19, 1, v19
    v_lshrrev_b32 v15, 1, v3
    v_or_b32 v19, v19, v15
    v_lshlrev_b32 v210, 1, v19
    v_lshl_or_b32 v210, v18, 4, v210
    s_and_b32 s49, s5, 1
    s_lshl_b32 s49, s49, 5
    s_lshr_b32 s50, s5, 1
    s_lshl_b32 s50, s50, 3
    s_add_u32 s49, s49, s50
    s_add_u32 s49, s49, 80128
    v_add_u32 v210, s49, v210
    v_lshlrev_b32 v211, 4, v3
    v_add_u32 v211, 80128, v211
    v_lshlrev_b32 v10, 4, v2
    v_lshl_or_b32 v10, v3, 8, v10
    v_lshrrev_b32 v11, 3, v1
    v_lshlrev_b32 v11, 11, v11
    v_and_b32 v15, 7, v1
    v_lshl_or_b32 v11, v15, 4, v11
    v_lshl_add_u32 v12, v19, 3, v15
    s_lshl_b32 s49, s5, 2
    s_add_u32 s49, s49, 78976
    v_lshl_add_u32 v12, v12, 4, s49
    v_and_b32 v15, 31, v1
    v_lshlrev_b32 v13, 4, v15
    v_add_u32 v13, 78976, v13
    v_mov_b32 v238, s46
    v_mov_b32 v239, s47
    s_lshl_b32 s40, s66, 11
    s_lshl_b32 s49, s5, 9
    s_add_u32 s40, s40, s49
    s_add_u32 s40, s40, 1048576
    s_lshl_b32 s49, s5, 16
    s_lshl_b32 s50, s4, 7
    s_add_u32 s49, s49, s50
    s_add_u32 s62, s49, 1048576
    s_add_u32 s42, s62, 16384
    s_add_u32 s43, s62, 32768
    s_add_u32 s100, s62, 49152
buffer_load_dwordx4 v[200:203], v26, s[24:27], s69 offen sc1
s_waitcnt vmcnt(4)
ds_read_b64_tr_b16 v[96:97], v14
ds_read_b64_tr_b16 v[98:99], v14 offset:4096
ds_read_b64_tr_b16 v[100:101], v65
ds_read_b64_tr_b16 v[102:103], v65 offset:4096
ds_read_b64_tr_b16 v[104:105], v66
ds_read_b64_tr_b16 v[106:107], v66 offset:4096
ds_read_b64_tr_b16 v[108:109], v67
ds_read_b64_tr_b16 v[110:111], v67 offset:4096
ds_read_b64_tr_b16 v[112:113], v68
ds_read_b64_tr_b16 v[114:115], v68 offset:4096
ds_read_b64_tr_b16 v[116:117], v69
ds_read_b64_tr_b16 v[118:119], v69 offset:4096
ds_read_b64_tr_b16 v[120:121], v70
ds_read_b64_tr_b16 v[122:123], v70 offset:4096
ds_read_b64_tr_b16 v[124:125], v71
ds_read_b64_tr_b16 v[126:127], v71 offset:4096
s_branch L_bwait

L_bpoll:
    buffer_load_dwordx4 v[200:203], v26, s[24:27], s69 offen sc1
L_bwait:
    s_waitcnt vmcnt(0)
    v_cmp_ne_u32 vcc, s46, v203
    s_cbranch_vccz L_bok

s_add_u32 s6, s6, 1
s_cmp_lt_u32 s6, 2097152
s_cbranch_scc1 L_bpoll
s_branch L_fin
L_bok:

    v_max_f32_dpp v204, v202, v202 row_ror:8 row_mask:0xf bank_mask:0xf
    v_lshlrev_b32 v206, 16, v200
    v_and_b32 v207, 0xffff0000, v200
    v_max_f32_dpp v204, v204, v204 row_ror:4 row_mask:0xf bank_mask:0xf
    v_lshlrev_b32 v208, 16, v201
    v_and_b32 v209, 0xffff0000, v201
    v_max_f32_dpp v204, v204, v204 row_ror:2 row_mask:0xf bank_mask:0xf
v_mov_b32 v205, v204
    s_nop 1
v_permlane16_swap_b32 v204, v205
v_max_f32 v204, v204, v205
v_mov_b32 v205, v204
    s_nop 1
v_permlane32_swap_b32 v204, v205
v_max_f32 v204, v204, v205

    v_sub_f32 v204, v202, v204
    v_exp_f32 v204, v204
    s_nop 0
    v_mul_f32 v206, v206, v204
    v_mul_f32 v207, v207, v204
    v_mul_f32 v208, v208, v204
    v_mul_f32 v209, v209, v204
    v_mov_b32 v205, v204
    v_permlane32_swap_b32 v206, v207
    v_permlane32_swap_b32 v208, v209
    v_permlane32_swap_b32 v204, v205
    v_add_f32 v206, v206, v207
    v_add_f32 v208, v208, v209
    v_add_f32 v204, v204, v205
    v_mov_b32 v205, v204
    v_permlane16_swap_b32 v206, v208
    s_nop 0
    v_permlane16_swap_b32 v204, v205
    v_add_f32 v206, v206, v208
    v_add_f32 v204, v204, v205
    s_nop 0
v_add_f32_dpp v206, v206, v206 row_ror:8 row_mask:0xf bank_mask:0xf
v_add_f32_dpp v204, v204, v204 row_ror:8 row_mask:0xf bank_mask:0xf
    s_nop 0
v_add_f32_dpp v206, v206, v206 row_ror:4 row_mask:0xf bank_mask:0xf
v_add_f32_dpp v204, v204, v204 row_ror:4 row_mask:0xf bank_mask:0xf
    s_nop 0
v_add_f32_dpp v206, v206, v206 row_ror:2 row_mask:0xf bank_mask:0xf
v_add_f32_dpp v204, v204, v204 row_ror:2 row_mask:0xf bank_mask:0xf

    v_rcp_f32 v204, v204
    s_nop 0
    v_mul_f32 v206, v206, v204
    v_cvt_pk_bf16_f32 v206, v206, v206
s_mov_b32 exec_lo, 0x30003
s_mov_b32 exec_hi, 0x30003
ds_write_b16 v210, v206
s_mov_b64 exec, -1
s_waitcnt lgkmcnt(0)
s_barrier
ds_read_b128 v[208:211], v211
s_waitcnt lgkmcnt(0)
v_mfma_f32_16x16x32_bf16 v[160:163], v[208:211], v[96:99], 0
v_mfma_f32_16x16x32_bf16 v[164:167], v[208:211], v[100:103], 0
v_mfma_f32_16x16x32_bf16 v[168:171], v[208:211], v[104:107], 0
v_mfma_f32_16x16x32_bf16 v[172:175], v[208:211], v[108:111], 0
v_mfma_f32_16x16x32_bf16 v[176:179], v[208:211], v[112:115], 0
v_mfma_f32_16x16x32_bf16 v[180:183], v[208:211], v[116:119], 0
v_mfma_f32_16x16x32_bf16 v[184:187], v[208:211], v[120:123], 0
v_mfma_f32_16x16x32_bf16 v[188:191], v[208:211], v[124:127], 0

    s_nop 4
    v_cndmask_b32 v200, v160, v176, s[52:53]
    v_cndmask_b32 v201, v164, v180, s[52:53]
    v_cndmask_b32 v202, v168, v184, s[52:53]
    v_cndmask_b32 v203, v172, v188, s[52:53]
    v_cvt_pk_bf16_f32 v236, v200, v201
    v_cvt_pk_bf16_f32 v237, v202, v203
s_mov_b32 exec_lo, 0xffffffff
s_mov_b32 exec_hi, 0x0
buffer_store_dwordx4 v[236:239], v10, s[24:27], s40 offen sc1
s_mov_b64 exec, -1
s_sleep 10
buffer_load_dwordx4 v[32:35], v11, s[24:27], s62 offen sc1
buffer_load_dwordx4 v[36:39], v11, s[24:27], s42 offen sc1
buffer_load_dwordx4 v[40:43], v11, s[24:27], s43 offen sc1
buffer_load_dwordx4 v[44:47], v11, s[24:27], s100 offen sc1
s_sleep 5
buffer_load_dwordx4 v[48:51], v11, s[24:27], s62 offen sc1
buffer_load_dwordx4 v[52:55], v11, s[24:27], s42 offen sc1
buffer_load_dwordx4 v[56:59], v11, s[24:27], s43 offen sc1
buffer_load_dwordx4 v[60:63], v11, s[24:27], s100 offen sc1
L_cpoll:
s_waitcnt vmcnt(4)
v_dot2_f32_bf16 v216, v32, s58, 0
v_dot2_f32_bf16 v217, v32, s59, 0
v_dot2_f32_bf16 v218, v33, s58, 0
v_dot2_f32_bf16 v219, v33, s59, 0
v_dot2_f32_bf16 v216, v36, s58, v216
v_dot2_f32_bf16 v217, v36, s59, v217
v_dot2_f32_bf16 v218, v37, s58, v218
v_dot2_f32_bf16 v219, v37, s59, v219
v_dot2_f32_bf16 v216, v40, s58, v216
v_dot2_f32_bf16 v217, v40, s59, v217
v_dot2_f32_bf16 v218, v41, s58, v218
v_dot2_f32_bf16 v219, v41, s59, v219
v_dot2_f32_bf16 v216, v44, s58, v216
v_dot2_f32_bf16 v217, v44, s59, v217
v_dot2_f32_bf16 v218, v45, s58, v218
v_dot2_f32_bf16 v219, v45, s59, v219
v_xor_b32 v34, s46, v34
v_xor_b32 v35, s47, v35
v_xor_b32 v38, s46, v38
v_xor_b32 v39, s47, v39
v_xor_b32 v42, s46, v42
v_xor_b32 v43, s47, v43
v_xor_b32 v46, s46, v46
v_xor_b32 v47, s47, v47
v_or_b32 v220, v34, v35
v_or3_b32 v220, v220, v38, v39
v_or3_b32 v220, v220, v42, v43
v_or3_b32 v220, v220, v46, v47
v_cmp_ne_u32 vcc, 0, v220
s_cbranch_vccz L_cok
buffer_load_dwordx4 v[32:35], v11, s[24:27], s62 offen sc1
buffer_load_dwordx4 v[36:39], v11, s[24:27], s42 offen sc1
buffer_load_dwordx4 v[40:43], v11, s[24:27], s43 offen sc1
buffer_load_dwordx4 v[44:47], v11, s[24:27], s100 offen sc1
s_waitcnt vmcnt(4)
v_dot2_f32_bf16 v216, v48, s58, 0
v_dot2_f32_bf16 v217, v48, s59, 0
v_dot2_f32_bf16 v218, v49, s58, 0
v_dot2_f32_bf16 v219, v49, s59, 0
v_dot2_f32_bf16 v216, v52, s58, v216
v_dot2_f32_bf16 v217, v52, s59, v217
v_dot2_f32_bf16 v218, v53, s58, v218
v_dot2_f32_bf16 v219, v53, s59, v219
v_dot2_f32_bf16 v216, v56, s58, v216
v_dot2_f32_bf16 v217, v56, s59, v217
v_dot2_f32_bf16 v218, v57, s58, v218
v_dot2_f32_bf16 v219, v57, s59, v219
v_dot2_f32_bf16 v216, v60, s58, v216
v_dot2_f32_bf16 v217, v60, s59, v217
v_dot2_f32_bf16 v218, v61, s58, v218
v_dot2_f32_bf16 v219, v61, s59, v219
v_xor_b32 v50, s46, v50
v_xor_b32 v51, s47, v51
v_xor_b32 v54, s46, v54
v_xor_b32 v55, s47, v55
v_xor_b32 v58, s46, v58
v_xor_b32 v59, s47, v59
v_xor_b32 v62, s46, v62
v_xor_b32 v63, s47, v63
v_or_b32 v220, v50, v51
v_or3_b32 v220, v220, v54, v55
v_or3_b32 v220, v220, v58, v59
v_or3_b32 v220, v220, v62, v63
v_cmp_ne_u32 vcc, 0, v220
s_cbranch_vccz L_cok
buffer_load_dwordx4 v[48:51], v11, s[24:27], s62 offen sc1
buffer_load_dwordx4 v[52:55], v11, s[24:27], s42 offen sc1
buffer_load_dwordx4 v[56:59], v11, s[24:27], s43 offen sc1
buffer_load_dwordx4 v[60:63], v11, s[24:27], s100 offen sc1
s_add_u32 s6, s6, 1
s_cmp_lt_u32 s6, 2097152
s_cbranch_scc1 L_cpoll
s_branch L_fin
L_cok:

    v_permlane32_swap_b32 v216, v217
    v_permlane32_swap_b32 v218, v219
    v_add_f32 v216, v216, v217
    v_add_f32 v218, v218, v219
    s_nop 1
    v_permlane16_swap_b32 v216, v218
    v_add_f32 v216, v216, v218
    s_nop 1
    v_add_f32_dpp v216, v216, v216 row_ror:8 row_mask:0xf bank_mask:0xf
s_mov_b32 exec_lo, 0xff00ff
s_mov_b32 exec_hi, 0xff00ff
ds_write_b32 v12, v216
s_mov_b64 exec, -1

    v_lshlrev_b32 v248, 16, v248
    s_lshl_b32 s48, s3, 11
    s_lshl_b32 s49, s60, 2
    s_add_u32 s48, s48, s49
    s_add_u32 s48, s48, 4096
    v_lshrrev_b32 v206, 3, v1
    v_lshlrev_b32 v206, 6, v206
    v_bfe_u32 v205, v1, 1, 2
    v_lshl_or_b32 v206, v205, 3, v206
    v_mov_b32 v205, s46
    v_and_b32 v207, 31, v1
    v_lshlrev_b32 v207, 2, v207
    v_add_u32 v207, 81792, v207
    s_waitcnt lgkmcnt(0)
    s_barrier
    s_cmp_lg_u32 s5, 0
    s_cbranch_scc1 L_wexit
    ds_read_b128 v[200:203], v13
    s_waitcnt lgkmcnt(0)
    v_add_f32 v200, v200, v201
    v_add_f32 v202, v202, v203
    v_add_f32 v200, v200, v202
v_cvt_pk_bf16_f32 v200, v200, v200
v_lshlrev_b32 v200, 16, v200
v_add_f32 v250, v248, v200
v_cvt_pk_bf16_f32 v250, v250, v250
v_lshlrev_b32 v250, 16, v250

    s_nop 1
    v_mov_b32_dpp v201, v250 quad_perm:[1,1,3,3] row_mask:0xf bank_mask:0xf
    ds_write_b32 v207, v250
    v_perm_b32 v204, v201, v250, s65
s_mov_b32 exec_lo, 0x55555555
s_mov_b32 exec_hi, 0x0
s_cmp_lg_u32 s68, 0
s_cbranch_scc1 L_lsg2
buffer_store_dwordx2 v[204:205], v206, s[24:27], s48 offen
s_branch L_lsd2
L_lsg2:
buffer_store_dwordx2 v[204:205], v206, s[24:27], s48 offen sc1
L_lsd2:
s_mov_b64 exec, -1

    v_lshrrev_b32 v11, 1, v1
    v_lshlrev_b32 v11, 12, v11
    v_lshl_or_b32 v11, v18, 4, v11
    s_lshr_b32 s50, s4, 1
    s_lshl_b32 s50, s50, 5
    s_and_b32 s51, s3, 1
    s_lshl_b32 s48, s51, 4
    s_add_u32 s50, s50, s48
    s_and_b32 s48, s4, 1
    s_lshl_b32 s48, s48, 3
    s_add_u32 s50, s50, s48
    s_and_b32 s48, s3, 6
    s_add_u32 s50, s50, s48
    s_lshl_b32 s50, s50, 4
    s_add_u32 s62, s50, 1310720
    s_add_u32 s42, s62, 131072
    v_lshrrev_b32 v15, 5, v1
    s_lshl_b32 s51, s51, 1
    v_add_u32 v15, s51, v15
    v_add_u32 v17, s48, v18
    v_lshl_add_u32 v16, v15, 3, v17
    v_lshlrev_b32 v16, 2, v16
    v_add_u32 v16, 81792, v16
    v_lshl_add_u32 v15, v15, 4, v17
    v_lshlrev_b32 v15, 1, v15
    s_lshl_b32 s50, s60, 1
    s_mov_b32 s16, s34
    s_mov_b32 s17, s35
    s_mov_b32 s18, 1024
    s_waitcnt lgkmcnt(0)
    ds_read_b32 v250, v16
v_mov_b32 v100, 0
v_mov_b32 v101, 0
v_mov_b32 v102, s46
v_mov_b32 v103, s47
v_mov_b32 v108, 0
v_mov_b32 v109, 0
v_mov_b32 v110, s46
v_mov_b32 v111, s47

    s_lshl_b32 s48, s3, 7
    s_add_u32 s48, s48, 24576
    v_lshlrev_b32 v17, 2, v1
    s_mov_b32 exec_lo, 0xfffffff
    s_mov_b32 exec_hi, 0
L_fpoll:
    buffer_load_dword v208, v17, s[24:27], s48 offen sc1
    s_waitcnt vmcnt(0)
    v_cmp_ne_u32 vcc, s46, v208
    s_cbranch_vccz L_fok
    s_sleep 1
s_add_u32 s6, s6, 1
s_cmp_lt_u32 s6, 2097152
s_cbranch_scc1 L_fpoll
s_branch L_fin
L_fok:
s_mov_b64 exec, -1
s_sleep 1
buffer_load_dwordx4 v[96:99], v11, s[24:27], s62 offen sc1
s_mov_b32 exec_lo, 0xffffffff
s_mov_b32 exec_hi, 0xffff
buffer_load_dwordx4 v[100:103], v11, s[24:27], s42 offen sc1
s_mov_b64 exec, -1
s_sleep 3
buffer_load_dwordx4 v[104:107], v11, s[24:27], s62 offen sc1
s_mov_b32 exec_lo, 0xffffffff
s_mov_b32 exec_hi, 0xffff
buffer_load_dwordx4 v[108:111], v11, s[24:27], s42 offen sc1
s_mov_b64 exec, -1
L_epoll:
s_waitcnt vmcnt(2)

    v_xor_b32 v204, s46, v98
    v_xor_b32 v205, s47, v99
    v_xor_b32 v206, s46, v102
    v_xor_b32 v207, s47, v103
    v_add_f32 v200, v96, v100
    v_or3_b32 v204, v204, v205, v206
    v_add_f32 v201, v97, v101
    v_or_b32 v204, v204, v207
    v_cmp_ne_u32 vcc, 0, v204
    s_cbranch_vccz L_eok
buffer_load_dwordx4 v[96:99], v11, s[24:27], s62 offen sc1
s_mov_b32 exec_lo, 0xffffffff
s_mov_b32 exec_hi, 0xffff
buffer_load_dwordx4 v[100:103], v11, s[24:27], s42 offen sc1
s_mov_b64 exec, -1
s_waitcnt vmcnt(2)

    v_xor_b32 v204, s46, v106
    v_xor_b32 v205, s47, v107
    v_xor_b32 v206, s46, v110
    v_xor_b32 v207, s47, v111
    v_add_f32 v200, v104, v108
    v_or3_b32 v204, v204, v205, v206
    v_add_f32 v201, v105, v109
    v_or_b32 v204, v204, v207
    v_cmp_ne_u32 vcc, 0, v204
    s_cbranch_vccz L_eok
buffer_load_dwordx4 v[104:107], v11, s[24:27], s62 offen sc1
s_mov_b32 exec_lo, 0xffffffff
s_mov_b32 exec_hi, 0xffff
buffer_load_dwordx4 v[108:111], v11, s[24:27], s42 offen sc1
s_mov_b64 exec, -1
s_add_u32 s6, s6, 1
s_cmp_lt_u32 s6, 2097152
s_cbranch_scc1 L_epoll
s_branch L_fin
L_eok:

    v_permlane32_swap_b32 v200, v201
    v_add_f32 v200, v200, v201
    v_mov_b32 v202, v200
    s_nop 1
    v_permlane16_swap_b32 v200, v202
    v_add_f32 v200, v200, v202
    s_nop 1
v_add_f32_dpp v200, v200, v200 row_ror:8 row_mask:0xf bank_mask:0xf
    s_nop 1
v_add_f32_dpp v200, v200, v200 row_ror:4 row_mask:0xf bank_mask:0xf
    s_nop 1
v_add_f32_dpp v200, v200, v200 row_ror:2 row_mask:0xf bank_mask:0xf
v_cvt_pk_bf16_f32 v200, v200, v200
v_lshlrev_b32 v200, 16, v200

    s_waitcnt lgkmcnt(0)
    v_add_f32 v200, v250, v200
    v_cvt_pk_bf16_f32 v200, v200, v200
s_mov_b32 exec_lo, 0x3
s_mov_b32 exec_hi, 0x3

    buffer_store_short v200, v15, s[16:19], s50 offen
s_mov_b64 exec, -1
s_endpgm
.p2align 12
L_warm1:
s_branch L_warm_ret
L_ftail:
s_cmp_ge_u32 s4, 23
s_cbranch_scc1 L_idle

    s_mov_b32 s12, s32
    s_mov_b32 s13, s33
    s_mov_b32 s14, 1835008
    s_lshl_b32 s48, s66, 6
    s_mul_i32 s49, s5, 458752
    s_add_u32 s48, s48, s49
    s_lshl_b32 s49, s5, 13
    s_add_u32 s49, s49, 32768
    s_mov_b32 m0, s49
    s_nop 0
buffer_load_dwordx4 v247, s[12:15], s48 offen offset:0 nt lds
s_add_u32 s48, s48, 56320
buffer_load_dwordx4 v247, s[12:15], s48 offen offset:1024 nt lds
s_add_u32 s48, s48, 56320
buffer_load_dwordx4 v247, s[12:15], s48 offen offset:2048 nt lds
s_add_u32 s48, s48, 56320
buffer_load_dwordx4 v247, s[12:15], s48 offen offset:3072 nt lds
s_add_u32 s48, s48, 60416
s_add_u32 s49, s49, 4096
s_mov_b32 m0, s49
    s_nop 0
buffer_load_dwordx4 v247, s[12:15], s48 offen offset:0 nt lds
s_add_u32 s48, s48, 56320
buffer_load_dwordx4 v247, s[12:15], s48 offen offset:1024 nt lds
s_add_u32 s48, s48, 56320
buffer_load_dwordx4 v247, s[12:15], s48 offen offset:2048 nt lds
s_add_u32 s48, s48, 56320
buffer_load_dwordx4 v247, s[12:15], s48 offen offset:3072 nt lds

    v_lshrrev_b32 v15, 2, v2
    v_lshl_or_b32 v15, v3, 2, v15
    v_and_b32 v16, 7, v15
    v_lshlrev_b32 v16, 5, v16
    v_lshl_or_b32 v16, v15, 8, v16
    v_and_b32 v15, 3, v2
    v_lshl_or_b32 v16, v15, 3, v16
    s_lshl_b32 s48, s5, 13
    v_add_u32 v14, s48, v16
v_xor_b32 v65, 32, v14
v_xor_b32 v66, 64, v14
v_xor_b32 v67, 96, v14
v_xor_b32 v68, 128, v14
v_xor_b32 v69, 160, v14
v_xor_b32 v70, 192, v14
v_xor_b32 v71, 224, v14
s_waitcnt vmcnt(11)
ds_read_b64_tr_b16 v[96:97], v14
ds_read_b64_tr_b16 v[98:99], v14 offset:4096
ds_read_b64_tr_b16 v[100:101], v65
ds_read_b64_tr_b16 v[102:103], v65 offset:4096
ds_read_b64_tr_b16 v[104:105], v66
ds_read_b64_tr_b16 v[106:107], v66 offset:4096
ds_read_b64_tr_b16 v[108:109], v67
ds_read_b64_tr_b16 v[110:111], v67 offset:4096
ds_read_b64_tr_b16 v[112:113], v68
ds_read_b64_tr_b16 v[114:115], v68 offset:4096
ds_read_b64_tr_b16 v[116:117], v69
ds_read_b64_tr_b16 v[118:119], v69 offset:4096
ds_read_b64_tr_b16 v[120:121], v70
ds_read_b64_tr_b16 v[122:123], v70 offset:4096
ds_read_b64_tr_b16 v[124:125], v71
ds_read_b64_tr_b16 v[126:127], v71 offset:4096

    s_lshl_b32 s48, s5, 13
    s_add_u32 s48, s48, 32768
    v_lshrrev_b32 v15, 2, v2
    v_lshl_or_b32 v15, v3, 2, v15
    v_lshlrev_b32 v15, 6, v15
    v_and_b32 v16, 1, v3
    v_lshl_or_b32 v15, v16, 5, v15
    v_and_b32 v16, 3, v2
    v_lshl_or_b32 v15, v16, 3, v15
    v_add_u32 v242, s48, v15
    v_xor_b32 v243, 32, v242
    v_lshl_or_b32 v15, v3, 4, v2
    v_lshlrev_b32 v15, 4, v15
    s_lshl_b32 s48, s5, 2
    s_add_u32 s48, s48, 78976
    v_add_u32 v244, s48, v15
    v_lshrrev_b32 v15, 2, v1
    v_lshlrev_b32 v15, 6, v15
    v_and_b32 v16, 1, v1
    v_lshl_or_b32 v15, v16, 5, v15
    v_bfe_u32 v16, v1, 1, 1
    v_lshl_or_b32 v15, v16, 3, v15
    v_add_u32 v240, 65536, v15
    s_lshl_b32 s48, s5, 8
    s_add_u32 s48, s48, 65536
    v_lshl_add_u32 v11, v3, 4, s48
    v_lshlrev_b32 v12, 4, v1
    v_add_u32 v12, 65536, v12
    v_and_b32 v215, 3, v2
    v_lshl_or_b32 v215, v3, 2, v215
    v_bfe_u32 v217, v2, 2, 1
    v_lshl_or_b32 v215, v217, 4, v215
    v_lshlrev_b32 v216, 4, v215
    v_add_u32 v216, 78976, v216
    s_lshl_b32 s40, s66, 12
    s_add_u32 s40, s40, 1310720
    v_lshlrev_b32 v10, 4, v2
    v_lshl_or_b32 v10, v3, 8, v10
    s_lshl_b32 s49, s5, 10
    s_add_u32 s40, s40, s49
    v_mov_b32 v238, s46
    v_mov_b32 v239, s47
    s_waitcnt vmcnt(0)
ds_read_b64_tr_b16 v[32:33], v242 offset:0
ds_read_b64_tr_b16 v[34:35], v242 offset:1024
ds_read_b64_tr_b16 v[36:37], v242 offset:2048
ds_read_b64_tr_b16 v[38:39], v242 offset:3072
ds_read_b64_tr_b16 v[40:41], v242 offset:4096
ds_read_b64_tr_b16 v[42:43], v242 offset:5120
ds_read_b64_tr_b16 v[44:45], v242 offset:6144
ds_read_b64_tr_b16 v[46:47], v242 offset:7168
ds_read_b64_tr_b16 v[48:49], v243 offset:0
ds_read_b64_tr_b16 v[50:51], v243 offset:1024
ds_read_b64_tr_b16 v[52:53], v243 offset:2048
ds_read_b64_tr_b16 v[54:55], v243 offset:3072
ds_read_b64_tr_b16 v[56:57], v243 offset:4096
ds_read_b64_tr_b16 v[58:59], v243 offset:5120
ds_read_b64_tr_b16 v[60:61], v243 offset:6144
ds_read_b64_tr_b16 v[62:63], v243 offset:7168
s_waitcnt lgkmcnt(0)
v_mfma_f32_16x16x32_bf16 v[160:163], v[252:255], v[32:35], 0
v_mfma_f32_16x16x32_bf16 v[164:167], v[252:255], v[48:51], 0
v_mfma_f32_16x16x32_bf16 v[160:163], v[252:255], v[36:39], v[160:163]
v_mfma_f32_16x16x32_bf16 v[164:167], v[252:255], v[52:55], v[164:167]
v_mfma_f32_16x16x32_bf16 v[160:163], v[252:255], v[40:43], v[160:163]
v_mfma_f32_16x16x32_bf16 v[164:167], v[252:255], v[56:59], v[164:167]
v_mfma_f32_16x16x32_bf16 v[160:163], v[252:255], v[44:47], v[160:163]
v_mfma_f32_16x16x32_bf16 v[164:167], v[252:255], v[60:63], v[164:167]
    s_nop 7
v_cndmask_b32 v246, v160, v164, s[52:53]

    s_sub_u32 s48, s4, 16
    s_lshl_b32 s48, s48, 2
    s_add_u32 s48, s48, s5
    s_lshl_b32 s48, s48, 2
    s_lshl_b32 s49, s3, 7
    s_add_u32 s48, s48, s49
    s_add_u32 s41, s48, 24576
    v_mov_b32 v17, 0

    s_cmp_lg_u32 s5, 0
    s_cbranch_scc1 L_hwait
L_hpoll:
    buffer_load_dwordx4 v[200:203], v26, s[24:27], s69 offen sc1
    buffer_load_dwordx4 v[204:207], v26, s[24:27], s69 offen offset:16 sc1
    s_waitcnt vmcnt(0)
    v_xor_b32 v208, s46, v201
    v_xor_b32 v209, s46, v203
    v_xor_b32 v210, s46, v205
    v_xor_b32 v211, s46, v207
    ds_write2_b32 v240, v200, v202 offset0:0 offset1:1
    v_or3_b32 v208, v208, v209, v210
    ds_write2_b32 v240, v204, v206 offset0:4 offset1:5
    v_or_b32 v208, v208, v211
    v_cmp_ne_u32 vcc, 0, v208
    s_cbranch_vccz L_hok
    s_sleep 1
s_add_u32 s6, s6, 1
s_cmp_lt_u32 s6, 2097152
s_cbranch_scc1 L_hpoll
s_branch L_fin
L_hok:
s_waitcnt lgkmcnt(0)
L_hwait:
s_barrier
ds_read_b128 v[200:203], v12
ds_read_b128 v[128:131], v11 offset:0
ds_read_b128 v[132:135], v11 offset:64
ds_read_b128 v[136:139], v11 offset:128
ds_read_b128 v[140:143], v11 offset:192
v_mov_b32 v212, 0
v_mov_b32 v213, 0
s_waitcnt lgkmcnt(4)
v_dot2_f32_bf16 v212, v200, v252, v212
v_dot2_f32_bf16 v213, v200, v200, v213
v_dot2_f32_bf16 v212, v201, v252, v212
v_dot2_f32_bf16 v213, v201, v201, v213
v_dot2_f32_bf16 v212, v202, v252, v212
v_dot2_f32_bf16 v213, v202, v202, v213
v_dot2_f32_bf16 v212, v203, v252, v212
v_dot2_f32_bf16 v213, v203, v203, v213
s_waitcnt lgkmcnt(0)
v_mfma_f32_16x16x32_bf16 v[192:195], v[128:131], v[32:35], 0
v_mfma_f32_16x16x32_bf16 v[196:199], v[128:131], v[48:51], 0
v_mfma_f32_16x16x32_bf16 v[192:195], v[132:135], v[36:39], v[192:195]
v_mfma_f32_16x16x32_bf16 v[196:199], v[132:135], v[52:55], v[196:199]
v_mfma_f32_16x16x32_bf16 v[192:195], v[136:139], v[40:43], v[192:195]
v_mfma_f32_16x16x32_bf16 v[196:199], v[136:139], v[56:59], v[196:199]
v_mfma_f32_16x16x32_bf16 v[192:195], v[140:143], v[44:47], v[192:195]
v_mfma_f32_16x16x32_bf16 v[196:199], v[140:143], v[60:63], v[196:199]
v_add_f32_dpp v212, v212, v212 row_ror:8 row_mask:0xf bank_mask:0xf
v_add_f32_dpp v213, v213, v213 row_ror:8 row_mask:0xf bank_mask:0xf
    s_nop 0
v_add_f32_dpp v212, v212, v212 row_ror:4 row_mask:0xf bank_mask:0xf
v_add_f32_dpp v213, v213, v213 row_ror:4 row_mask:0xf bank_mask:0xf
    s_nop 0
v_add_f32_dpp v212, v212, v212 row_ror:2 row_mask:0xf bank_mask:0xf
v_add_f32_dpp v213, v213, v213 row_ror:2 row_mask:0xf bank_mask:0xf
    s_nop 0
v_add_f32_dpp v212, v212, v212 row_ror:1 row_mask:0xf bank_mask:0xf
v_add_f32_dpp v213, v213, v213 row_ror:1 row_mask:0xf bank_mask:0xf
v_mov_b32 v214, v212
v_mov_b32 v219, v213
    s_nop 0
v_permlane16_swap_b32 v212, v214
v_permlane16_swap_b32 v213, v219
v_add_f32 v212, v212, v214
v_add_f32 v213, v213, v219
v_mov_b32 v214, v212
v_mov_b32 v219, v213
    s_nop 0
v_permlane32_swap_b32 v212, v214
v_permlane32_swap_b32 v213, v219
v_add_f32 v212, v212, v214
v_add_f32 v213, v213, v219

    v_mul_f32 v212, 0x3b000000, v212
    v_mul_f32 v213, 0x3b000000, v213
    v_fma_f32 v213, -v212, v212, v213
    v_max_f32 v213, 0, v213
v_cvt_pk_bf16_f32 v212, v212, v212
v_lshlrev_b32 v212, 16, v212
v_cvt_pk_bf16_f32 v213, v213, v213
v_lshlrev_b32 v213, 16, v213

    v_add_f32 v213, 0x3727c5ac, v213
    v_cndmask_b32 v214, v192, v196, s[52:53]
    v_fma_f32 v214, -v212, v246, v214
s_mov_b32 exec_lo, 0xffffffff
s_mov_b32 exec_hi, 0x0
ds_write_b32 v244, v214
s_mov_b64 exec, -1
v_cvt_pk_bf16_f32 v213, v213, v213
v_lshlrev_b32 v213, 16, v213
v_sqrt_f32 v213, v213
    s_nop 0
v_cvt_pk_bf16_f32 v213, v213, v213
v_lshlrev_b32 v213, 16, v213

    v_rcp_f32 v213, v213
    s_waitcnt lgkmcnt(0)
    s_barrier
    ds_read_b128 v[220:223], v216

    s_waitcnt lgkmcnt(0)
    v_add_f32 v220, v220, v221
    v_add_f32 v222, v222, v223
    v_add_f32 v220, v220, v222
    v_mul_f32 v220, v220, v213
v_cvt_pk_bf16_f32 v220, v220, v220
v_lshlrev_b32 v220, 16, v220

    v_mul_f32 v221, 0xbfb8aa3b, v220
    v_exp_f32 v221, v221
    s_nop 0
    v_add_f32 v221, 1.0, v221
    v_rcp_f32 v221, v221
    s_nop 0
    v_mul_f32 v220, v220, v221
    s_nop 1
    v_mov_b32_dpp v221, v220 quad_perm:[1,1,3,3] row_mask:0xf bank_mask:0xf
    v_cvt_pk_bf16_f32 v220, v220, v221
    s_nop 1
    v_mov_b32_dpp v208, v220 row_newbcast:0 row_mask:0xf bank_mask:0xf
    v_mov_b32_dpp v209, v220 row_newbcast:2 row_mask:0xf bank_mask:0xf
    v_mov_b32_dpp v210, v220 row_newbcast:4 row_mask:0xf bank_mask:0xf
    v_mov_b32_dpp v211, v220 row_newbcast:6 row_mask:0xf bank_mask:0xf
    s_nop 1
v_mfma_f32_16x16x32_bf16 v[160:163], v[208:211], v[96:99], 0
v_mfma_f32_16x16x32_bf16 v[164:167], v[208:211], v[100:103], 0
v_mfma_f32_16x16x32_bf16 v[168:171], v[208:211], v[104:107], 0
v_mfma_f32_16x16x32_bf16 v[172:175], v[208:211], v[108:111], 0
v_mfma_f32_16x16x32_bf16 v[176:179], v[208:211], v[112:115], 0
v_mfma_f32_16x16x32_bf16 v[180:183], v[208:211], v[116:119], 0
v_mfma_f32_16x16x32_bf16 v[184:187], v[208:211], v[120:123], 0
v_mfma_f32_16x16x32_bf16 v[188:191], v[208:211], v[124:127], 0

    s_nop 2
    v_cndmask_b32 v236, v160, v168, s[52:53]
    v_cndmask_b32 v237, v164, v172, s[52:53]
    v_cndmask_b32 v236, v236, v176, s[54:55]
    v_cndmask_b32 v237, v237, v180, s[54:55]
    v_cndmask_b32 v236, v236, v184, s[56:57]
    v_cndmask_b32 v237, v237, v188, s[56:57]
    buffer_store_dwordx4 v[236:239], v10, s[24:27], s40 offen sc1
s_mov_b64 exec, 1
s_cmp_lg_u32 s68, 0
s_cbranch_scc1 L_lsg3
buffer_store_dword v238, v17, s[24:27], s41 offen
s_branch L_lsd3
L_lsg3:
buffer_store_dword v238, v17, s[24:27], s41 offen sc1
L_lsd3:
s_mov_b64 exec, -1
s_branch L_fin
s_branch L_fin
L_wexit:

    s_cmp_lg_u32 s2, 0
    s_cbranch_scc1 L_fin
    s_cmp_lg_u32 s5, 1
    s_cbranch_scc1 L_fin
    s_mov_b64 exec, 1
    v_mov_b32 v203, s46
    buffer_store_dword v203, off, s[24:27], 0 sc1
    s_mov_b64 exec, -1
s_branch L_fin
L_idle:
L_fin:
L_end:
s_endpgm

.section .rodata,"a"
.p2align 6
.amdhsa_kernel sequential_preLN__sliding_block_cached__dense_activation_silu__decode_kernel
  .amdhsa_next_free_vgpr 256
  .amdhsa_next_free_sgpr 102
  .amdhsa_accum_offset 256
  .amdhsa_group_segment_fixed_size 0
  .amdhsa_kernarg_size 88
  .amdhsa_user_sgpr_count 2
  .amdhsa_user_sgpr_kernarg_segment_ptr 1
  .amdhsa_system_sgpr_workgroup_id_x 1
  .amdhsa_float_denorm_mode_32 3
  .amdhsa_float_denorm_mode_16_64 3
.end_amdhsa_kernel
```
